```python
import torch

def _softmax(x, axis=-1):
    return torch.softmax(x, dim=axis)
def _gelu(x):
    return torch.nn.functional.gelu(x, approximate="tanh")
def _silu(x):
    return torch.nn.functional.silu(x)
def _sigmoid(x):
    return torch.sigmoid(x)
def _layernorm(x, axis=-1, eps=1e-5):
    m = x.mean(dim=axis, keepdim=True)
    v = x.var(dim=axis, keepdim=True, unbiased=False)
    return (x - m) / torch.sqrt(v + eps)
def _scatter_add(tgt, idx, src, axis=0):
    return tgt.clone().index_add_(axis, idx, src)
def _segment_sum(src, seg, n):
    out = torch.zeros((n,) + src.shape[1:], dtype=src.dtype)
    return out.index_add_(0, seg, src)
def _pad(x, pw):
    flat = tuple(v for pair in reversed(pw) for v in pair)
    return torch.nn.functional.pad(x, flat)

kernel_name = 'standalone__moe_arch_mod__prompt'

def setup_inputs():

    _w = (lambda a: (lambda t: t.to(torch.bfloat16) if t.is_floating_point() else t)(torch.as_tensor(a)))
    B, S, D, F, C = 1, 2048, 1024, 3584, 2
    return {
        "x": _w((lambda *s: torch.randn(*s, dtype=torch.bfloat16) * 0.1)(B, S, D)),
        "w_r": _w((lambda *s: torch.randn(*s, dtype=torch.bfloat16) * 0.1)(D)),
        "w_gate": _w((lambda *s: torch.randn(*s, dtype=torch.bfloat16) * 0.1)(D, F)),
        "w_up": _w((lambda *s: torch.randn(*s, dtype=torch.bfloat16) * 0.1)(D, F)),
        "w_down": _w((lambda *s: torch.randn(*s, dtype=torch.bfloat16) * 0.1)(F, D)),
    }

def reference(x, w_r, w_gate, w_up, w_down):
    B, S, D = x.shape
    C = 2
    r = x @ w_r
    idx = torch.argsort(-r, axis=-1)[:, :C]
    idx_e = (lambda x, n, axis: torch.repeat_interleave(x, n, dim=axis))(idx.reshape(B, C, 1), D, axis=2)
    x_sel = (lambda x, i, axis: torch.take_along_dim(x, i, dim=axis))(x, idx_e, axis=1)
    g = _silu(x_sel @ w_gate)
    u = x_sel @ w_up
    y = (g * u) @ w_down
    r_sel = _sigmoid((lambda x, i, axis: torch.take_along_dim(x, i, dim=axis))(r, idx, axis=1))
    y = y * r_sel.reshape(B, C, 1)
    b_off = (torch.arange(B) * S).reshape(B, 1)
    flat_idx = (idx + b_off).reshape(B * C)
    zero = (x * 0.0).reshape(B * S, D)
    upd = _scatter_add(zero, flat_idx, y.reshape(B * C, D), axis=0)
    return x + upd.reshape(B, S, D)
```

```asm
; @launch grid=(256,1,1) block=(576,1,1) lds=12800
.amdgcn_target "amdgcn-amd-amdhsa--gfx950"
.text
.p2align 12
.globl standalone__moe_arch_mod__prompt_kernel
.p2align 8
.type standalone__moe_arch_mod__prompt_kernel,@function
standalone__moe_arch_mod__prompt_kernel:
    s_load_dwordx16 s[4:19], s[0:1], 0
    v_readfirstlane_b32 s3, v0
    s_cmp_ge_u32 s2, 256
    s_cbranch_scc1 L_end
    v_and_b32 v0, 63, v0
    s_lshr_b32 s3, s3, 6
    s_cmp_ge_u32 s3, 5
    s_cbranch_scc1 L_stubD
    s_cmp_lg_u32 s3, 0
    s_cbranch_scc1 L_Lstart
    s_lshl_b32 s35, s2, 3
    s_lshl_b32 s48, s2, 3
    s_add_u32 s20, s2, 4
    s_and_b32 s20, s20, 7
    s_mul_i32 s20, s20, 7
    s_lshr_b32 s21, s2, 5
    s_add_u32 s32, s20, s21
    s_bfe_u32 s33, s2, 0x20003
    s_cmp_ge_u32 s2, 224
    s_cselect_b32 s21, 0, s32
    s_and_b32 s21, s21, 7
    s_cmp_eq_u32 s21, 3
L_R1:
    s_cselect_b32 s55, 0x40000000, 0
    s_setprio 3
    s_lshl_b32 s43, s35, 11
    s_add_u32 s44, s43, 4096
    v_lshlrev_b32 v1, 4, v0
    v_add_u32 v90, s44, v1
    s_add_u32 s44, s44, 4096
    s_or_b32 s44, s44, s55
    s_add_u32 s45, s44, 4096
    s_mov_b32 s22, 4194304
    s_mov_b32 s23, 0x20000
    v_mov_b32 v88, 0
    v_mov_b32 v84, -1
    v_mov_b32 v85, 0
    s_mov_b64 exec, 1
    ds_write_b64 v88, v[84:85] offset:16
    s_mov_b64 exec, -1
    s_waitcnt lgkmcnt(0)
    global_load_dwordx4 v[10:13], v90, s[4:5] offset:-4096
    global_load_dwordx4 v[14:17], v90, s[4:5] offset:-3072
    global_load_dwordx4 v[2:5], v1, s[6:7]
    global_load_dwordx4 v[6:9], v1, s[6:7] offset:1024
    s_mov_b32 s20, s4
    s_mov_b32 s21, s5
    global_load_dwordx4 v[18:21], v90, s[4:5] offset:-2048
    global_load_dwordx4 v[22:25], v90, s[4:5] offset:-1024
    global_load_dwordx4 v[26:29], v90, s[4:5] offset:0
    global_load_dwordx4 v[30:33], v90, s[4:5] offset:1024
    global_load_dwordx4 v[34:37], v90, s[4:5] offset:2048
    global_load_dwordx4 v[38:41], v90, s[4:5] offset:3072
    buffer_load_dwordx4 v[42:45], v1, s[20:23], s44 offen offset:0
    buffer_load_dwordx4 v[46:49], v1, s[20:23], s44 offen offset:1024
    buffer_load_dwordx4 v[50:53], v1, s[20:23], s44 offen offset:2048
    buffer_load_dwordx4 v[54:57], v1, s[20:23], s44 offen offset:3072
    buffer_load_dwordx4 v[58:61], v1, s[20:23], s45 offen offset:0
    buffer_load_dwordx4 v[62:65], v1, s[20:23], s45 offen offset:1024
    buffer_load_dwordx4 v[66:69], v1, s[20:23], s45 offen offset:2048
    buffer_load_dwordx4 v[70:73], v1, s[20:23], s45 offen offset:3072
    s_load_dword s46, s[18:19], 0
    s_barrier
    s_branch L_R2
L_Lstart:
    s_cmp_ge_u32 s2, 224
    s_cbranch_scc1 L_stubR
    s_add_u32 s20, s2, 4
    s_and_b32 s20, s20, 7
    s_mul_i32 s20, s20, 7
    s_lshr_b32 s21, s2, 5
    s_add_u32 s32, s20, s21
    s_bfe_u32 s33, s2, 0x20003
    v_lshrrev_b32 v1, 4, v0
    v_and_b32 v2, 15, v0
    s_sub_u32 s34, s3, 1
    s_lshl_b32 s20, s33, 8
    s_lshl_b32 s21, s34, 6
    s_add_u32 s20, s20, s21
    s_mul_i32 s21, s20, 7168
    s_lshl_b32 s22, s32, 7
    s_add_u32 s21, s21, s22
    v_cmp_gt_u32 vcc, 8, v2
    v_and_b32 v3, 7, v2
    v_lshlrev_b32 v3, 4, v3
    v_mul_u32_u24 v4, 28672, v1
    v_add3_u32 v3, v3, v4, s21
    s_mov_b32 s22, 7168
    s_mov_b32 s23, 0
    s_mov_b32 s24, 93184
    s_mov_b32 s25, 0
    s_waitcnt lgkmcnt(0)
    v_mov_b32 v4, s10
    v_mov_b32 v5, s8
    v_mov_b32 v6, s11
    v_mov_b32 v7, s9
    v_cndmask_b32 v4, v4, v5, vcc
    v_cndmask_b32 v5, v6, v7, vcc
    v_add_co_u32 v4, vcc, v4, v3
    v_mov_b32 v6, 0
    v_mov_b32 v7, 1
    v_addc_co_u32 v5, vcc, 0, v5, vcc
    s_barrier
    global_load_dwordx4 v[32:35], v[4:5], off nt
    v_lshl_add_u64 v[4:5], v[4:5], 0, s[22:23]
    global_load_dwordx4 v[36:39], v[4:5], off nt
    v_lshl_add_u64 v[4:5], v[4:5], 0, s[22:23]
    global_load_dwordx4 v[40:43], v[4:5], off nt
    v_lshl_add_u64 v[4:5], v[4:5], 0, s[22:23]
    global_load_dwordx4 v[44:47], v[4:5], off nt
    v_lshl_add_u64 v[4:5], v[4:5], 0, s[24:25]
    global_load_dwordx4 v[48:51], v[4:5], off nt
    v_lshl_add_u64 v[4:5], v[4:5], 0, s[22:23]
    s_branch L_L2
L_stubD:
    s_cmp_ge_u32 s2, 224
    s_cbranch_scc1 L_stubA
    s_cmp_eq_u32 s3, 5
    s_cbranch_scc1 L_PF
    s_cmp_lg_u32 s3, 8
    s_cbranch_scc1 L_nocpf
    s_getpc_b64 s[22:23]
L_pc:
    v_lshlrev_b32 v1, 7, v0
    v_min_u32 v1, L_hot_end-L_pc, v1
    global_load_dword v80, v1, s[22:23]
L_nocpf:
    s_barrier
    s_branch L_D
L_stubA:
    s_cmp_lg_u32 s3, 5
    s_cbranch_scc1 L_end
L_stubH:
    s_waitcnt lgkmcnt(0)
    s_load_dword s46, s[18:19], 0
    s_waitcnt lgkmcnt(0)
    s_barrier
    s_cmp_eq_u32 s3, 5
    s_cbranch_scc1 L_AGG
    s_branch L_RED
L_stubR:
    s_cmp_ge_u32 s3, 3
    s_cbranch_scc0 L_stubH
    s_cmp_lg_u32 s3, 3
    s_cbranch_scc1 L_end
    s_add_u32 s20, s2, 7
    s_and_b32 s20, s20, 7
    s_cmp_eq_u32 s20, 7
    s_cbranch_scc1 L_end
    s_lshl_b32 s21, s20, 5
    s_and_b32 s35, s2, 31
    s_add_u32 s35, s35, s21
    s_lshl_b32 s35, s35, 3
    s_add_u32 s35, s35, 4
    s_and_b32 s48, s2, 31
    s_lshl_b32 s48, s48, 3
    s_add_u32 s48, s48, 2048
    s_cmp_eq_u32 s20, s20
    s_branch L_R1
L_PF:
    s_add_u32 s20, s2, 4
    s_and_b32 s20, s20, 7
    s_mul_i32 s20, s20, 7
    s_lshr_b32 s21, s2, 5
    s_add_u32 s32, s20, s21
    s_bfe_u32 s33, s2, 0x20003
    s_sub_u32 s22, 3, s20
    s_and_b32 s22, s22, 7
    s_cmp_gt_u32 s21, s22
    s_subb_u32 s23, s21, 0
    s_cmp_eq_u32 s21, s22
    s_cselect_b32 s23, 7, s23
    s_cmp_eq_u32 s22, 7
    s_cselect_b32 s23, 7, s23
    s_cmp_ge_u32 s23, 6
    s_cbranch_scc1 L_nocpf
    s_add_u32 s23, s23, 10
    s_lshr_b32 s24, s23, 2
    s_lshl_b32 s24, s24, 4
    s_and_b32 s23, s23, 3
    s_add_u32 s23, s23, s24
    s_lshl_b32 s24, s33, 8
    s_add_u32 s23, s23, s24
    s_mul_i32 s23, s23, 7168
    s_add_u32 s22, s22, s20
    s_lshl_b32 s22, s22, 7
    s_add_u32 s23, s23, s22
    v_bfe_u32 v1, v0, 3, 2
    v_mul_u32_u24 v1, 458752, v1
    v_bfe_u32 v2, v0, 1, 2
    v_mul_u32_u24 v2, 28672, v2
    v_add3_u32 v1, v1, v2, s23
    v_and_b32 v2, 1, v0
    v_cmp_eq_u32 vcc, 0, v2
    s_waitcnt lgkmcnt(0)
    v_mov_b32 v4, s10
    v_mov_b32 v5, s8
    v_mov_b32 v6, s11
    v_mov_b32 v7, s9
    v_cndmask_b32 v4, v4, v5, vcc
    v_cndmask_b32 v5, v6, v7, vcc
    v_add_co_u32 v4, vcc, v4, v1
    s_nop 1
    v_addc_co_u32 v5, vcc, 0, v5, vcc
    s_mov_b32 exec_hi, 0
    s_barrier
    global_load_dword v80, v[4:5], off
    s_mov_b64 exec, -1
    s_branch L_D
L_R2:
    s_mov_b32 s28, s18
    s_mov_b32 s29, s19
    s_mov_b32 s30, 268435456
    s_mov_b32 s31, 0x20000
    s_mov_b32 s24, s14
    s_mov_b32 s25, s15
    s_mov_b32 s26, 4194304
    s_mov_b32 s27, 0x20000
    v_lshrrev_b32 v82, 5, v0
    v_bfe_u32 v83, v0, 4, 1
    v_lshl_or_b32 v82, v83, 1, v82
    v_bfe_u32 v83, v0, 3, 1
    v_lshl_or_b32 v82, v83, 2, v82
    s_sub_u32 s47, 2047, s35
    v_sub_u32 v82, s47, v82
    v_mul_u32_u24 v92, 2304, v0
    s_add_u32 s48, s48, 131072
    s_cmp_lg_u32 s55, 0
    s_cselect_b32 s56, 0xff00ff00, 0
    s_mov_b32 s57, s56
    v_mov_b32 v74, 0
    v_mov_b32 v75, 0
    v_mov_b32 v76, 0
    v_mov_b32 v77, 0
    v_mov_b32 v78, 0
    v_mov_b32 v79, 0
    v_mov_b32 v80, 0
    v_mov_b32 v81, 0
    v_mov_b32 v93, 0x207
    s_waitcnt lgkmcnt(0)
    s_mul_i32 s50, s46, 0x9e3779b8
    s_add_u32 s50, s50, 0x3c6ef372
    s_xor_b32 s51, s50, 0xa5a5a5a8
    s_mul_i32 s52, s46, 0x85ebca6b
    s_add_u32 s52, s52, 0x27d4eb2f
    v_mov_b32 v84, s52
    s_mov_b64 exec, 1
    ds_write_b32 v88, v84 offset:0
    s_mov_b64 exec, -1
    s_waitcnt vmcnt(14)
    v_dot2c_f32_bf16 v74, v10, v2
    v_dot2c_f32_bf16 v74, v11, v3
    v_dot2c_f32_bf16 v74, v12, v4
    v_dot2c_f32_bf16 v74, v13, v5
    v_dot2c_f32_bf16 v74, v14, v6
    v_dot2c_f32_bf16 v74, v15, v7
    v_dot2c_f32_bf16 v74, v16, v8
    v_dot2c_f32_bf16 v74, v17, v9
    s_waitcnt vmcnt(12)
    v_dot2c_f32_bf16 v75, v18, v2
    v_dot2c_f32_bf16 v75, v19, v3
    v_dot2c_f32_bf16 v75, v20, v4
    v_dot2c_f32_bf16 v75, v21, v5
    v_dot2c_f32_bf16 v75, v22, v6
    v_dot2c_f32_bf16 v75, v23, v7
    v_dot2c_f32_bf16 v75, v24, v8
    v_dot2c_f32_bf16 v75, v25, v9
    s_waitcnt vmcnt(10)
    v_dot2c_f32_bf16 v76, v26, v2
    v_dot2c_f32_bf16 v76, v27, v3
    v_dot2c_f32_bf16 v76, v28, v4
    v_dot2c_f32_bf16 v76, v29, v5
    v_dot2c_f32_bf16 v76, v30, v6
    v_dot2c_f32_bf16 v76, v31, v7
    v_dot2c_f32_bf16 v76, v32, v8
    v_dot2c_f32_bf16 v76, v33, v9
    s_waitcnt vmcnt(8)
    v_dot2c_f32_bf16 v77, v34, v2
    v_dot2c_f32_bf16 v77, v35, v3
    v_dot2c_f32_bf16 v77, v36, v4
    v_dot2c_f32_bf16 v77, v37, v5
    v_dot2c_f32_bf16 v77, v38, v6
    v_dot2c_f32_bf16 v77, v39, v7
    v_dot2c_f32_bf16 v77, v40, v8
    v_dot2c_f32_bf16 v77, v41, v9
    s_waitcnt vmcnt(6)
    v_dot2c_f32_bf16 v78, v42, v2
    v_dot2c_f32_bf16 v78, v43, v3
    v_dot2c_f32_bf16 v78, v44, v4
    v_dot2c_f32_bf16 v78, v45, v5
    v_dot2c_f32_bf16 v78, v46, v6
    v_dot2c_f32_bf16 v78, v47, v7
    v_dot2c_f32_bf16 v78, v48, v8
    v_dot2c_f32_bf16 v78, v49, v9
    s_waitcnt vmcnt(4)
    v_dot2c_f32_bf16 v79, v50, v2
    v_dot2c_f32_bf16 v79, v51, v3
    v_dot2c_f32_bf16 v79, v52, v4
    v_dot2c_f32_bf16 v79, v53, v5
    v_dot2c_f32_bf16 v79, v54, v6
    v_dot2c_f32_bf16 v79, v55, v7
    v_dot2c_f32_bf16 v79, v56, v8
    v_dot2c_f32_bf16 v79, v57, v9
    s_waitcnt vmcnt(2)
    v_dot2c_f32_bf16 v80, v58, v2
    v_dot2c_f32_bf16 v80, v59, v3
    v_dot2c_f32_bf16 v80, v60, v4
    v_dot2c_f32_bf16 v80, v61, v5
    v_dot2c_f32_bf16 v80, v62, v6
    v_dot2c_f32_bf16 v80, v63, v7
    v_dot2c_f32_bf16 v80, v64, v8
    v_dot2c_f32_bf16 v80, v65, v9
    v_permlane32_swap_b32 v74, v75
    v_permlane32_swap_b32 v76, v77
    v_permlane32_swap_b32 v78, v79
    v_add_f32 v74, v74, v75
    v_add_f32 v76, v76, v77
    v_add_f32 v78, v78, v79
    s_waitcnt vmcnt(1)
    v_dot2c_f32_bf16 v81, v66, v2
    v_dot2c_f32_bf16 v81, v67, v3
    v_dot2c_f32_bf16 v81, v68, v4
    v_dot2c_f32_bf16 v81, v69, v5
    v_permlane16_swap_b32 v74, v76
    s_waitcnt vmcnt(0)
    v_dot2c_f32_bf16 v81, v70, v6
    v_dot2c_f32_bf16 v81, v71, v7
    v_dot2c_f32_bf16 v81, v72, v8
    v_dot2c_f32_bf16 v81, v73, v9
    v_add_f32 v74, v74, v76
    s_nop 1
    v_permlane32_swap_b32 v80, v81
    v_add_f32_dpp v75, v74, v74 row_ror:8 row_mask:0xf bank_mask:0xf
    v_add_f32 v80, v80, v81
    s_nop 1
    v_permlane16_swap_b32 v78, v80
    v_add_f32 v78, v78, v80
    s_nop 1
    v_add_f32_dpp v75, v78, v78 row_ror:8 row_mask:0xf bank_mask:0xc
    s_nop 1
    v_add_f32_dpp v75, v75, v75 row_half_mirror row_mask:0xf bank_mask:0xf
    s_nop 1
    v_add_f32_dpp v75, v75, v75 quad_perm:[1,0,3,2] row_mask:0xf bank_mask:0xf
    s_nop 1
    v_add_f32_dpp v79, v75, v75 quad_perm:[2,3,0,1] row_mask:0xf bank_mask:0xf
    v_cmp_u_f32 vcc, v79, v79
    v_cvt_pk_bf16_f32 v76, v79, v79
    v_ashrrev_i32 v77, 31, v76
    v_or_b32 v77, 0x80000000, v77
    v_xor_b32 v76, v76, v77
    v_lshrrev_b32 v76, 16, v76
    v_cndmask_b32 v76, v76, 0, vcc
    v_lshl_or_b32 v76, v76, 11, v82
    v_cndmask_b32 v76, v76, 0, s[56:57]
    s_nop 1
    v_max_u32_dpp v74, v76, v76 row_ror:8 row_mask:0xf bank_mask:0xf
    v_max_u32_dpp v78, v76, v76 row_ror:8 row_mask:0xf bank_mask:0xf
    v_min_u32_dpp v75, v76, v76 row_ror:8 row_mask:0xf bank_mask:0xf
    v_min_u32_dpp v77, v76, v76 row_ror:8 row_mask:0xf bank_mask:0xf
    s_nop 0
    v_permlane16_swap_b32 v74, v78
    v_permlane16_swap_b32 v75, v77
    v_min_u32 v80, v74, v78
    v_max_u32 v76, v74, v78
    v_max_u32 v74, v74, v78
    v_max3_u32 v81, v75, v77, v80
    v_max3_u32 v75, v75, v77, v80
    v_permlane32_swap_b32 v74, v76
    s_nop 0
    v_permlane32_swap_b32 v75, v81
    v_min_u32 v78, v74, v76
    v_max_u32 v74, v74, v76
    v_max3_u32 v75, v75, v81, v78
    v_xor_b32 v74, s50, v74
    v_xor_b32 v75, s51, v75
    s_mov_b64 exec, 0xff
    buffer_store_dwordx2 v[74:75], v92, s[28:31], s48 offen sc1
    s_cmp_lt_u32 s2, 224
    s_cbranch_scc1 L_Rnob
    s_waitcnt vmcnt(0)
    s_barrier
L_Rnob:
    s_mov_b64 exec, -1
    v_cmp_class_f32 vcc, v79, v93
    s_cbranch_vccnz L_nanfix
L_nanfix_done:
    s_mov_b64 exec, 1
    s_and_b32 s44, s2, 7
    s_lshl_b32 s44, s44, 13
    s_add_u32 s44, s44, 4096
    s_mov_b32 s45, 63
L_rp_1:
    s_load_dwordx4 s[40:43], s[18:19], s44
    s_add_u32 s44, s44, 128
    s_sub_u32 s45, s45, 1
    s_cbranch_scc1 L_rf_2
    s_waitcnt lgkmcnt(0)
    s_cmp_lg_u32 s43, s52
    s_cbranch_scc1 L_rp_1
L_rd_4:
    v_mov_b32 v84, s40
    ds_write_b32 v88, v84 offset:16
    s_mov_b64 exec, -1
    s_setprio 0
    s_and_b32 s41, s40, 0x7ff
    s_bfe_u32 s40, s40, 0xb0010
    s_mov_b32 s42, s35
    s_lshl_b32 s43, s35, 11
    s_cmp_eq_u32 s42, s40
    s_cselect_b32 s60, 0x40000000, s43
    s_cmp_eq_u32 s42, s41
    s_cselect_b32 s60, 0x40000000, s60
    s_add_u32 s43, s43, 2048
    s_add_u32 s42, s42, 1
    s_cmp_eq_u32 s42, s40
    s_cselect_b32 s61, 0x40000000, s43
    s_cmp_eq_u32 s42, s41
    s_cselect_b32 s61, 0x40000000, s61
    s_add_u32 s43, s43, 2048
    s_add_u32 s42, s42, 1
    s_cmp_eq_u32 s42, s40
    s_cselect_b32 s62, 0x40000000, s43
    s_cmp_eq_u32 s42, s41
    s_cselect_b32 s62, 0x40000000, s62
    s_add_u32 s43, s43, 2048
    s_add_u32 s42, s42, 1
    s_cmp_eq_u32 s42, s40
    s_cselect_b32 s63, 0x40000000, s43
    s_cmp_eq_u32 s42, s41
    s_cselect_b32 s63, 0x40000000, s63
    s_add_u32 s43, s43, 2048
    s_add_u32 s42, s42, 1
    s_or_b32 s43, s43, s55
    s_cmp_eq_u32 s42, s40
    s_cselect_b32 s64, 0x40000000, s43
    s_cmp_eq_u32 s42, s41
    s_cselect_b32 s64, 0x40000000, s64
    s_add_u32 s43, s43, 2048
    s_add_u32 s42, s42, 1
    s_cmp_eq_u32 s42, s40
    s_cselect_b32 s65, 0x40000000, s43
    s_cmp_eq_u32 s42, s41
    s_cselect_b32 s65, 0x40000000, s65
    s_add_u32 s43, s43, 2048
    s_add_u32 s42, s42, 1
    s_cmp_eq_u32 s42, s40
    s_cselect_b32 s66, 0x40000000, s43
    s_cmp_eq_u32 s42, s41
    s_cselect_b32 s66, 0x40000000, s66
    s_add_u32 s43, s43, 2048
    s_add_u32 s42, s42, 1
    s_cmp_eq_u32 s42, s40
    s_cselect_b32 s67, 0x40000000, s43
    s_cmp_eq_u32 s42, s41
    s_cselect_b32 s67, 0x40000000, s67
    s_cmp_ge_u32 s2, 224
    s_cbranch_scc1 L_rstore
    s_barrier
    s_barrier
    s_sleep 12
L_rstore:
    buffer_store_dwordx4 v[10:13], v1, s[24:27], s60 offen sc1
    buffer_store_dwordx4 v[14:17], v1, s[24:27], s60 offen offset:1024 sc1
    buffer_store_dwordx4 v[18:21], v1, s[24:27], s61 offen sc1
    buffer_store_dwordx4 v[22:25], v1, s[24:27], s61 offen offset:1024 sc1
    buffer_store_dwordx4 v[26:29], v1, s[24:27], s62 offen sc1
    buffer_store_dwordx4 v[30:33], v1, s[24:27], s62 offen offset:1024 sc1
    buffer_store_dwordx4 v[34:37], v1, s[24:27], s63 offen sc1
    buffer_store_dwordx4 v[38:41], v1, s[24:27], s63 offen offset:1024 sc1
    buffer_store_dwordx4 v[42:45], v1, s[24:27], s64 offen sc1
    buffer_store_dwordx4 v[46:49], v1, s[24:27], s64 offen offset:1024 sc1
    buffer_store_dwordx4 v[50:53], v1, s[24:27], s65 offen sc1
    buffer_store_dwordx4 v[54:57], v1, s[24:27], s65 offen offset:1024 sc1
    buffer_store_dwordx4 v[58:61], v1, s[24:27], s66 offen sc1
    buffer_store_dwordx4 v[62:65], v1, s[24:27], s66 offen offset:1024 sc1
    buffer_store_dwordx4 v[66:69], v1, s[24:27], s67 offen sc1
    buffer_store_dwordx4 v[70:73], v1, s[24:27], s67 offen offset:1024 sc1
    s_endpgm
L_L2:
    v_and_b32 v8, 1, v0
    v_cmp_eq_u32 vcc, 1, v8
    v_mov_b32 v9, 0x0c0c0100
    v_mov_b32 v10, 0x01000c0c
    v_mov_b32 v11, 0x0c0c0302
    v_mov_b32 v12, 0x03020c0c
    v_cndmask_b32 v9, v9, v10, vcc
    v_cndmask_b32 v10, v11, v12, vcc
    v_bfe_u32 v8, v0, 1, 2
    v_mov_b32 v11, 0x0c0c0c0c
    v_cmp_eq_u32 vcc, 0, v8
    s_nop 1
    v_cndmask_b32 v16, v11, v9, vcc
    v_cndmask_b32 v20, v11, v10, vcc
    v_cmp_eq_u32 vcc, 1, v8
    s_nop 1
    v_cndmask_b32 v17, v11, v9, vcc
    v_cndmask_b32 v21, v11, v10, vcc
    v_cmp_eq_u32 vcc, 2, v8
    s_nop 1
    v_cndmask_b32 v18, v11, v9, vcc
    v_cndmask_b32 v22, v11, v10, vcc
    v_cmp_eq_u32 vcc, 3, v8
    s_nop 1
    v_cndmask_b32 v19, v11, v9, vcc
    v_cndmask_b32 v23, v11, v10, vcc
    s_mov_b32 s28, s18
    s_mov_b32 s29, s19
    s_mov_b32 s30, 268435456
    s_mov_b32 s31, 0x20000
    s_lshl_b32 s20, s20, 1
    v_bfe_u32 v8, v2, 1, 2
    v_lshlrev_b32 v9, 8, v8
    v_and_b32 v8, 1, v2
    v_lshl_or_b32 v9, v8, 7, v9
    v_and_b32 v8, 1, v1
    v_lshl_or_b32 v9, v8, 6, v9
    v_lshrrev_b32 v8, 1, v1
    v_lshl_or_b32 v9, v8, 5, v9
    v_lshrrev_b32 v8, 3, v2
    v_lshl_or_b32 v1, v8, 4, v9
    v_lshlrev_b32 v0, 4, v0
    s_lshl_b32 s21, s34, 10
    v_add_u32 v2, s21, v0
    s_lshl_b32 s12, s32, 2
    s_add_u32 s12, s12, s33
    s_lshl_b32 s12, s12, 10
    s_add_u32 s12, s12, 393216
    s_add_u32 s4, s4, s20
    s_addc_u32 s5, s5, 0
    s_mov_b32 s21, 1048576
    s_waitcnt vmcnt(4)
    global_load_dwordx4 v[52:55], v[4:5], off nt
    v_lshl_add_u64 v[4:5], v[4:5], 0, s[22:23]
    s_waitcnt vmcnt(5)
    global_load_dwordx4 v[56:59], v[4:5], off nt
    v_lshl_add_u64 v[4:5], v[4:5], 0, s[22:23]
    s_waitcnt vmcnt(5)
    global_load_dwordx4 v[60:63], v[4:5], off nt
    v_lshl_add_u64 v[4:5], v[4:5], 0, s[24:25]
    s_waitcnt vmcnt(5)
    global_load_dwordx4 v[64:67], v[4:5], off nt
    v_lshl_add_u64 v[4:5], v[4:5], 0, s[22:23]
    s_waitcnt vmcnt(5)
    global_load_dwordx4 v[68:71], v[4:5], off nt
    v_lshl_add_u64 v[4:5], v[4:5], 0, s[22:23]
    s_mov_b64 exec, 1
    ds_add_u32 v6, v7 offset:20
    s_mov_b64 exec, -1
    s_waitcnt vmcnt(5)
    global_load_dwordx4 v[72:75], v[4:5], off nt
    v_lshl_add_u64 v[4:5], v[4:5], 0, s[22:23]
    s_waitcnt vmcnt(5)
    global_load_dwordx4 v[76:79], v[4:5], off nt
    v_lshl_add_u64 v[4:5], v[4:5], 0, s[24:25]
    s_waitcnt vmcnt(5)
    global_load_dwordx4 v[80:83], v[4:5], off nt
    v_lshl_add_u64 v[4:5], v[4:5], 0, s[22:23]
    s_waitcnt vmcnt(5)
    global_load_dwordx4 v[84:87], v[4:5], off nt
    v_lshl_add_u64 v[4:5], v[4:5], 0, s[22:23]
    s_waitcnt vmcnt(5)
    global_load_dwordx4 v[88:91], v[4:5], off nt
    v_lshl_add_u64 v[4:5], v[4:5], 0, s[22:23]
    s_waitcnt vmcnt(5)
    global_load_dwordx4 v[92:95], v[4:5], off nt
L_Lroute:
    ds_read_b32 v3, v6 offset:16
    s_sub_u32 s21, s21, 1
    s_cbranch_scc1 L_Lroute_done
    s_waitcnt lgkmcnt(0)
    v_readfirstlane_b32 s8, v3
    s_cmp_eq_u32 s8, -1
    s_cbranch_scc1 L_Lroute
L_Lroute_done:
    s_lshr_b32 s9, s8, 5
    s_and_b32 s9, s9, 0x3ff800
    s_load_dwordx16 s[36:51], s[4:5], s9
    s_load_dwordx16 s[52:67], s[4:5], s9 offset:64
    s_lshl_b32 s9, s8, 11
    s_and_b32 s9, s9, 0x3ff800
    s_load_dwordx16 s[68:83], s[4:5], s9
    s_load_dwordx16 s[84:99], s[4:5], s9 offset:64
    ds_read_b32 v3, v6 offset:0
L_Lx:
    s_mov_b64 exec, 0xff
    s_waitcnt lgkmcnt(0)
    v_readfirstlane_b32 s26, v3
    v_mov_b64 v[8:9], s[36:37]
    v_mov_b64 v[10:11], s[44:45]
    v_mov_b64 v[12:13], s[52:53]
    v_mov_b64 v[14:15], s[60:61]
    s_lshl_b64 exec, exec, 8
    v_mov_b64 v[8:9], s[68:69]
    v_mov_b64 v[10:11], s[76:77]
    v_mov_b64 v[12:13], s[84:85]
    v_mov_b64 v[14:15], s[92:93]
    s_lshl_b64 exec, exec, 8
    v_mov_b64 v[8:9], s[38:39]
    v_mov_b64 v[10:11], s[46:47]
    v_mov_b64 v[12:13], s[54:55]
    v_mov_b64 v[14:15], s[62:63]
    s_lshl_b64 exec, exec, 8
    v_mov_b64 v[8:9], s[70:71]
    v_mov_b64 v[10:11], s[78:79]
    v_mov_b64 v[12:13], s[86:87]
    v_mov_b64 v[14:15], s[94:95]
    s_lshl_b64 exec, exec, 8
    v_mov_b64 v[8:9], s[40:41]
    v_mov_b64 v[10:11], s[48:49]
    v_mov_b64 v[12:13], s[56:57]
    v_mov_b64 v[14:15], s[64:65]
    s_lshl_b64 exec, exec, 8
    v_mov_b64 v[8:9], s[72:73]
    v_mov_b64 v[10:11], s[80:81]
    v_mov_b64 v[12:13], s[88:89]
    v_mov_b64 v[14:15], s[96:97]
    s_lshl_b64 exec, exec, 8
    v_mov_b64 v[8:9], s[42:43]
    v_mov_b64 v[10:11], s[50:51]
    v_mov_b64 v[12:13], s[58:59]
    v_mov_b64 v[14:15], s[66:67]
    s_lshl_b64 exec, exec, 8
    v_mov_b64 v[8:9], s[74:75]
    v_mov_b64 v[10:11], s[82:83]
    v_mov_b64 v[12:13], s[90:91]
    v_mov_b64 v[14:15], s[98:99]
    s_mov_b64 exec, -1
    v_perm_b32 v24, v8, v8, v16
    v_perm_b32 v25, v8, v8, v17
    v_perm_b32 v26, v8, v8, v18
    v_perm_b32 v27, v8, v8, v19
    v_perm_b32 v28, v8, v8, v20
    v_perm_b32 v29, v8, v8, v21
    v_perm_b32 v30, v8, v8, v22
    v_perm_b32 v31, v8, v8, v23
    s_waitcnt vmcnt(12)
    v_mfma_f32_16x16x32_bf16 v[4:7], v[24:27], v[32:35], 0
    v_perm_b32 v24, v9, v9, v16
    v_perm_b32 v25, v9, v9, v17
    v_perm_b32 v26, v9, v9, v18
    v_perm_b32 v27, v9, v9, v19
    v_mfma_f32_16x16x32_bf16 v[4:7], v[28:31], v[36:39], v[4:7]
    v_perm_b32 v28, v9, v9, v20
    v_perm_b32 v29, v9, v9, v21
    v_perm_b32 v30, v9, v9, v22
    v_perm_b32 v31, v9, v9, v23
    v_mfma_f32_16x16x32_bf16 v[4:7], v[24:27], v[40:43], v[4:7]
    v_perm_b32 v24, v10, v10, v16
    v_perm_b32 v25, v10, v10, v17
    v_perm_b32 v26, v10, v10, v18
    v_perm_b32 v27, v10, v10, v19
    v_mfma_f32_16x16x32_bf16 v[4:7], v[28:31], v[44:47], v[4:7]
    v_perm_b32 v28, v10, v10, v20
    v_perm_b32 v29, v10, v10, v21
    v_perm_b32 v30, v10, v10, v22
    v_perm_b32 v31, v10, v10, v23
    s_waitcnt vmcnt(8)
    v_mfma_f32_16x16x32_bf16 v[4:7], v[24:27], v[48:51], v[4:7]
    v_perm_b32 v24, v11, v11, v16
    v_perm_b32 v25, v11, v11, v17
    v_perm_b32 v26, v11, v11, v18
    v_perm_b32 v27, v11, v11, v19
    v_mfma_f32_16x16x32_bf16 v[4:7], v[28:31], v[52:55], v[4:7]
    v_perm_b32 v28, v11, v11, v20
    v_perm_b32 v29, v11, v11, v21
    v_perm_b32 v30, v11, v11, v22
    v_perm_b32 v31, v11, v11, v23
    v_mfma_f32_16x16x32_bf16 v[4:7], v[24:27], v[56:59], v[4:7]
    v_perm_b32 v24, v12, v12, v16
    v_perm_b32 v25, v12, v12, v17
    v_perm_b32 v26, v12, v12, v18
    v_perm_b32 v27, v12, v12, v19
    v_mfma_f32_16x16x32_bf16 v[4:7], v[28:31], v[60:63], v[4:7]
    v_perm_b32 v28, v12, v12, v20
    v_perm_b32 v29, v12, v12, v21
    v_perm_b32 v30, v12, v12, v22
    v_perm_b32 v31, v12, v12, v23
    s_waitcnt vmcnt(5)
    v_mfma_f32_16x16x32_bf16 v[4:7], v[24:27], v[64:67], v[4:7]
    v_perm_b32 v24, v13, v13, v16
    v_perm_b32 v25, v13, v13, v17
    v_perm_b32 v26, v13, v13, v18
    v_perm_b32 v27, v13, v13, v19
    v_mfma_f32_16x16x32_bf16 v[4:7], v[28:31], v[68:71], v[4:7]
    v_perm_b32 v28, v13, v13, v20
    v_perm_b32 v29, v13, v13, v21
    v_perm_b32 v30, v13, v13, v22
    v_perm_b32 v31, v13, v13, v23
    v_mfma_f32_16x16x32_bf16 v[4:7], v[24:27], v[72:75], v[4:7]
    v_perm_b32 v24, v14, v14, v16
    v_perm_b32 v25, v14, v14, v17
    v_perm_b32 v26, v14, v14, v18
    v_perm_b32 v27, v14, v14, v19
    s_waitcnt vmcnt(3)
    v_mfma_f32_16x16x32_bf16 v[4:7], v[28:31], v[76:79], v[4:7]
    v_perm_b32 v28, v14, v14, v20
    v_perm_b32 v29, v14, v14, v21
    v_perm_b32 v30, v14, v14, v22
    v_perm_b32 v31, v14, v14, v23
    v_mfma_f32_16x16x32_bf16 v[4:7], v[24:27], v[80:83], v[4:7]
    v_perm_b32 v24, v15, v15, v16
    v_perm_b32 v25, v15, v15, v17
    v_perm_b32 v26, v15, v15, v18
    v_perm_b32 v27, v15, v15, v19
    s_waitcnt vmcnt(2)
    v_mfma_f32_16x16x32_bf16 v[4:7], v[28:31], v[84:87], v[4:7]
    v_perm_b32 v28, v15, v15, v20
    v_perm_b32 v29, v15, v15, v21
    v_perm_b32 v30, v15, v15, v22
    v_perm_b32 v31, v15, v15, v23
    s_waitcnt vmcnt(1)
    v_mfma_f32_16x16x32_bf16 v[4:7], v[24:27], v[88:91], v[4:7]
    s_waitcnt vmcnt(0)
    v_mfma_f32_16x16x32_bf16 v[4:7], v[28:31], v[92:95], v[4:7]
    s_cmp_eq_u32 s34, 0
    s_cbranch_scc1 L_L0
    s_nop 5
    ds_write_b128 v2, v[4:7] offset:64
    s_waitcnt lgkmcnt(0)
    s_barrier
    s_endpgm
L_L0:
    s_and_b32 s27, s26, 15
    s_add_u32 s14, s27, 5
    s_add_u32 s15, s27, 10
    s_add_u32 s16, s27, 15
    s_barrier
    ds_read_b128 v[8:11], v0 offset:1088
    ds_read_b128 v[12:15], v0 offset:2112
    ds_read_b128 v[24:27], v0 offset:3136
    s_waitcnt lgkmcnt(2)
    v_pk_add_f32 v[4:5], v[4:5], v[8:9]
    v_pk_add_f32 v[6:7], v[6:7], v[10:11]
    s_waitcnt lgkmcnt(0)
    v_pk_add_f32 v[12:13], v[12:13], v[24:25]
    v_pk_add_f32 v[14:15], v[14:15], v[26:27]
    v_pk_add_f32 v[4:5], v[4:5], v[12:13]
    v_pk_add_f32 v[6:7], v[6:7], v[14:15]
    v_bfi_b32 v4, 15, s27, v4
    v_bfi_b32 v5, 15, s14, v5
    v_bfi_b32 v6, 15, s15, v6
    v_bfi_b32 v7, 15, s16, v7
    buffer_store_dwordx4 v[4:7], v1, s[28:31], s12 offen
    s_barrier
    s_endpgm
L_D:
    s_add_u32 s20, s2, 4
    s_and_b32 s20, s20, 7
    s_mul_i32 s20, s20, 7
    s_lshr_b32 s21, s2, 5
    s_add_u32 s32, s20, s21
    s_bfe_u32 s33, s2, 0x20003
    v_lshrrev_b32 v1, 4, v0
    v_and_b32 v2, 15, v0
    s_sub_u32 s34, s3, 5
    v_lshlrev_b32 v64, 13, v1
    v_lshl_or_b32 v64, v2, 4, v64
    s_lshl_b32 s20, s32, 6
    s_lshl_b32 s21, s34, 4
    s_add_u32 s20, s20, s21
    s_lshl_b32 s20, s20, 11
    s_lshl_b32 s21, s33, 9
    s_add_u32 s20, s20, s21
    s_add_u32 s21, s20, 4096
    s_waitcnt lgkmcnt(0)
    s_mov_b32 s36, s12
    s_mov_b32 s37, s13
    s_mov_b32 s38, 7340032
    s_mov_b32 s39, 0x20000
    s_mov_b32 s28, s18
    s_mov_b32 s29, s19
    s_mov_b32 s30, 268435456
    s_mov_b32 s31, 0x20000
    s_cmp_lg_u32 s34, 1
    s_cbranch_scc1 L_notouch
    s_lshr_b32 s22, s2, 3
    s_mul_i32 s22, s22, 3
    v_add_u32 v8, s22, v0
    v_min_u32 v8, 63, v8
    v_lshlrev_b32 v8, 7, v8
    s_and_b32 s22, s2, 7
    s_lshl_b32 s22, s22, 13
    s_add_u32 s22, s22, 4096
    s_mov_b64 exec, 7
    buffer_load_dword v80, v8, s[28:31], s22 offen sc1
    s_mov_b64 exec, -1
L_notouch:
    v_and_b32 v3, 1, v0
    v_cmp_eq_u32 vcc, 1, v3
    v_mov_b32 v4, 0x0c0c0100
    v_mov_b32 v5, 0x01000c0c
    v_mov_b32 v6, 0x0c0c0302
    v_mov_b32 v7, 0x03020c0c
    v_cndmask_b32 v4, v4, v5, vcc
    v_cndmask_b32 v5, v6, v7, vcc
    v_bfe_u32 v3, v0, 1, 2
    v_mov_b32 v6, 0x0c0c0c0c
    v_cmp_eq_u32 vcc, 0, v3
    s_nop 1
    v_cndmask_b32 v16, v6, v4, vcc
    v_cndmask_b32 v20, v6, v5, vcc
    v_cmp_eq_u32 vcc, 1, v3
    s_nop 1
    v_cndmask_b32 v17, v6, v4, vcc
    v_cndmask_b32 v21, v6, v5, vcc
    v_cmp_eq_u32 vcc, 2, v3
    s_nop 1
    v_cndmask_b32 v18, v6, v4, vcc
    v_cndmask_b32 v22, v6, v5, vcc
    v_cmp_eq_u32 vcc, 3, v3
    s_nop 1
    v_cndmask_b32 v19, v6, v4, vcc
    v_cndmask_b32 v23, v6, v5, vcc
    v_lshlrev_b32 v65, 4, v0
    s_lshl_b32 s22, s34, 11
    v_add_u32 v66, s22, v65
    s_lshl_b32 s22, s34, 10
    v_add_u32 v67, s22, v65
    s_lshl_b32 s23, s32, 2
    s_add_u32 s23, s23, s33
    s_lshl_b32 s23, s23, 11
    s_add_u32 s23, s23, s22
    s_add_u32 s23, s23, 1048576
    v_lshrrev_b32 v3, 1, v2
    v_lshlrev_b32 v68, 7, v3
    v_lshrrev_b32 v3, 1, v1
    v_lshl_or_b32 v68, v3, 6, v68
    v_and_b32 v3, 1, v2
    v_and_b32 v4, 1, v1
    v_lshl_or_b32 v3, v3, 1, v4
    v_lshl_or_b32 v68, v3, 4, v68
    v_mul_u32_u24 v71, 5, v3
    s_and_b32 s48, s2, 7
    s_lshl_b32 s48, s48, 7
    s_lshr_b32 s49, s2, 3
    s_lshl_b32 s49, s49, 2
    s_add_u32 s48, s48, s49
    s_add_u32 s48, s48, 77824
    s_lshl_b32 s22, s34, 8
    v_lshl_add_u32 v69, v0, 2, s22
    v_and_b32 v4, 3, v0
    v_mul_u32_u24 v70, 5, v4
    s_lshl_b32 s41, s32, 12
    s_add_u32 s41, s41, 393216
    s_mov_b32 s42, 64
    s_mov_b32 s43, 0xbfb8aa3b
    s_lshl_b32 s44, s33, 10
    s_add_u32 s44, s44, s41
    v_mov_b32 v3, 0
    s_mov_b32 s22, 262144
L_Dcnt:
    s_sleep 1
    ds_read_b32 v4, v3 offset:20
    s_sub_u32 s22, s22, 1
    s_cbranch_scc1 L_Dcnt_done
    s_waitcnt lgkmcnt(0)
    v_readfirstlane_b32 s45, v4
    s_cmp_lt_u32 s45, 4
    s_cbranch_scc1 L_Dcnt
L_Dcnt_done:
    buffer_load_dword v8, v69, s[28:31], s41 offen offset:0 sc1
    buffer_load_dword v9, v69, s[28:31], s41 offen offset:1024 sc1
    buffer_load_dword v10, v69, s[28:31], s41 offen offset:2048 sc1
    buffer_load_dword v11, v69, s[28:31], s41 offen offset:3072 sc1
    s_waitcnt vmcnt(0)
    buffer_load_dwordx4 v[32:35], v64, s[36:39], s20 offen offset:0 nt
    buffer_load_dwordx4 v[36:39], v64, s[36:39], s20 offen offset:256 nt
    buffer_load_dwordx4 v[40:43], v64, s[36:39], s20 offen offset:2048 nt
    buffer_load_dwordx4 v[44:47], v64, s[36:39], s20 offen offset:2304 nt
L_Droute:
    s_sleep 1
    ds_read_b32 v4, v3 offset:16
    s_sub_u32 s22, s22, 1
    s_cbranch_scc1 L_Droute_done
    s_waitcnt lgkmcnt(0)
    v_readfirstlane_b32 s45, v4
    s_cmp_eq_u32 s45, -1
    s_cbranch_scc1 L_Droute
L_Droute_done:
    buffer_load_dwordx4 v[48:51], v64, s[36:39], s21 offen offset:0 nt
    buffer_load_dwordx4 v[52:55], v64, s[36:39], s21 offen offset:256 nt
    buffer_load_dwordx4 v[56:59], v64, s[36:39], s21 offen offset:2048 nt
    buffer_load_dwordx4 v[60:63], v64, s[36:39], s21 offen offset:2304 nt
    s_barrier
    ds_read_b32 v72, v3 offset:0
    s_waitcnt lgkmcnt(0)
    v_readfirstlane_b32 s27, v72
    v_add_u32 v70, v70, v72
    v_add_u32 v71, v71, v72
    v_and_b32 v70, 15, v70
    s_sleep 2
L_poll2:
    buffer_load_dword v8, v69, s[28:31], s41 offen offset:0 sc1
    buffer_load_dword v9, v69, s[28:31], s41 offen offset:1024 sc1
    buffer_load_dword v10, v69, s[28:31], s41 offen offset:2048 sc1
    buffer_load_dword v11, v69, s[28:31], s41 offen offset:3072 sc1
    s_sub_u32 s42, s42, 1
    s_cbranch_scc1 L_p2sw
    s_waitcnt vmcnt(0)
    v_xor_b32 v8, v8, v70
    v_xor_b32 v9, v9, v70
    v_xor_b32 v10, v10, v70
    v_xor_b32 v11, v11, v70
    v_add_f32 v14, v8, v9
    v_or3_b32 v12, v8, v9, v10
    v_add_f32 v15, v10, v11
    v_bitop3_b32 v12, v12, v11, 15 bitop3:0xa8
    v_add_f32 v8, v14, v15
    v_cvt_pk_bf16_f32 v8, v8, v8
    v_and_b32 v8, 0xffff0000, v8
    v_cmp_ne_u32 vcc, 0, v12
    v_mul_f32 v9, s43, v8
    s_cbranch_vccnz L_poll2
L_poll2_done:
    v_exp_f32 v9, v9
    s_nop 0
    v_add_f32 v9, 1.0, v9
    v_rcp_f32 v9, v9
    s_nop 0
    v_mul_f32 v9, v8, v9
    v_cvt_pk_bf16_f32 v9, v9, v9
    v_and_b32 v9, 0xffff0000, v9
    v_mul_f32_dpp v10, v8, v9 row_shl:4 row_mask:0xf bank_mask:0x5
    s_nop 0
    v_mul_f32_dpp v10, v9, v8 row_shr:4 row_mask:0xf bank_mask:0xa
    s_nop 1
    v_mov_b32_dpp v8, v10 quad_perm:[0,0,0,0] row_mask:0xf bank_mask:0xf
    v_mov_b32_dpp v11, v10 quad_perm:[1,1,1,1] row_mask:0xf bank_mask:0xf
    v_mov_b32_dpp v9, v10 quad_perm:[2,2,2,2] row_mask:0xf bank_mask:0xf
    v_cvt_pk_bf16_f32 v8, v8, v11
    v_mov_b32_dpp v12, v10 quad_perm:[3,3,3,3] row_mask:0xf bank_mask:0xf
    v_perm_b32 v24, v8, v8, v16
    v_perm_b32 v25, v8, v8, v17
    v_perm_b32 v26, v8, v8, v18
    v_perm_b32 v27, v8, v8, v19
    v_cvt_pk_bf16_f32 v9, v9, v12
    v_perm_b32 v28, v8, v8, v20
    v_perm_b32 v29, v8, v8, v21
    v_perm_b32 v30, v8, v8, v22
    v_perm_b32 v31, v8, v8, v23
    v_mfma_f32_16x16x32_bf16 v[4:7], v[24:27], v[32:35], 0
    v_mfma_f32_16x16x32_bf16 v[12:15], v[24:27], v[36:39], 0
    v_perm_b32 v24, v9, v9, v16
    v_perm_b32 v25, v9, v9, v17
    v_perm_b32 v26, v9, v9, v18
    v_perm_b32 v27, v9, v9, v19
    v_mfma_f32_16x16x32_bf16 v[4:7], v[28:31], v[40:43], v[4:7]
    v_mfma_f32_16x16x32_bf16 v[12:15], v[28:31], v[44:47], v[12:15]
    v_perm_b32 v28, v9, v9, v20
    v_perm_b32 v29, v9, v9, v21
    v_perm_b32 v30, v9, v9, v22
    v_perm_b32 v31, v9, v9, v23
    v_mfma_f32_16x16x32_bf16 v[4:7], v[24:27], v[48:51], v[4:7]
    v_mfma_f32_16x16x32_bf16 v[12:15], v[24:27], v[52:55], v[12:15]
    v_mfma_f32_16x16x32_bf16 v[4:7], v[28:31], v[56:59], v[4:7]
    v_mfma_f32_16x16x32_bf16 v[12:15], v[28:31], v[60:63], v[12:15]
    s_cmp_ge_u32 s34, 2
    s_nop 5
    ds_write_b128 v66, v[4:7] offset:4608
    ds_write_b128 v66, v[12:15] offset:5632
    s_waitcnt lgkmcnt(0)
    s_barrier
    s_cbranch_scc1 L_D_copy
    ds_read_b128 v[4:7], v67 offset:4608
    ds_read_b128 v[8:11], v67 offset:6656
    ds_read_b128 v[12:15], v67 offset:8704
    ds_read_b128 v[24:27], v67 offset:10752
    s_waitcnt lgkmcnt(2)
    v_pk_add_f32 v[4:5], v[4:5], v[8:9]
    v_pk_add_f32 v[6:7], v[6:7], v[10:11]
    s_waitcnt lgkmcnt(0)
    v_pk_add_f32 v[12:13], v[12:13], v[24:25]
    v_pk_add_f32 v[14:15], v[14:15], v[26:27]
    v_pk_add_f32 v[4:5], v[4:5], v[12:13]
    v_pk_add_f32 v[6:7], v[6:7], v[14:15]
    v_bfi_b32 v4, 15, v71, v4
    buffer_store_dwordx4 v[4:7], v68, s[28:31], s23 offen sc1
L_D_done:
    s_endpgm
L_D_copy:
    s_cmp_lg_u32 s34, 3
    s_cbranch_scc1 L_D_copy2
    s_mov_b64 exec, 1
    buffer_store_dword v72, v3, s[28:31], s48 offen
    s_branch L_D_done
L_D_copy2:
    buffer_load_dwordx4 v[8:11], v65, s[28:31], s44 offen sc1
    s_add_u32 s45, s44, 262144
    s_waitcnt vmcnt(0)
    buffer_store_dwordx4 v[8:11], v65, s[28:31], s45 offen sc1
    s_branch L_D_done
L_RED:
    s_sub_u32 s34, s3, 1
    s_sub_u32 s44, s2, 224
    s_lshl_b32 s45, s44, 1
    s_add_u32 s45, s45, s34
    s_lshl_b32 s60, s45, 7
    v_lshrrev_b32 v1, 3, v0
    v_and_b32 v2, 7, v0
    v_lshlrev_b32 v3, 13, v1
    v_lshl_or_b32 v3, v2, 4, v3
    s_add_u32 s36, s18, 1048576
    s_addc_u32 s37, s19, 0
    s_mov_b32 s38, 458752
    s_mov_b32 s39, 0x20000
    s_add_u32 s61, s60, 65536
    s_add_u32 s62, s61, 65536
    s_add_u32 s63, s62, 65536
    s_add_u32 s64, s63, 65536
    s_add_u32 s65, s64, 65536
    s_add_u32 s66, s65, 65536
    v_bfe_u32 v4, v0, 4, 1
    v_bfe_u32 v5, v0, 5, 1
    v_lshl_or_b32 v4, v4, 1, v5
    v_and_b32 v40, 3, v0
    v_lshl_or_b32 v4, v40, 2, v4
    s_lshl_b32 s50, s45, 4
    v_add_lshl_u32 v4, v4, s50, 1
    v_and_b32 v5, 4, v0
    v_cmp_ne_u32 s[56:57], 0, v5
    s_and_b32 s48, s2, 7
    s_lshl_b32 s48, s48, 7
    s_add_u32 s48, s48, 77824
    v_lshlrev_b32 v41, 2, v0
    s_mul_i32 s50, s46, 0x9e3779b8
    s_add_u32 s50, s50, 0x3c6ef372
    s_xor_b32 s51, s50, 0xa5a5a5a8
    s_mul_i32 s52, s46, 0x85ebca6b
    s_add_u32 s52, s52, 0x27d4eb2f
    s_and_b32 s27, s52, 15
    v_mad_u32_u24 v40, v40, 5, s27
    v_and_b32 v40, 15, v40
    s_mov_b32 s28, s18
    s_mov_b32 s29, s19
    s_mov_b32 s30, 268435456
    s_mov_b32 s31, 0x20000
    s_barrier
    s_and_b32 s44, s2, 7
    s_lshl_b32 s44, s44, 13
    s_add_u32 s44, s44, 4096
    s_mov_b32 s45, 63
L_rp_5:
    s_load_dwordx4 s[40:43], s[18:19], s44
    s_add_u32 s44, s44, 128
    s_sub_u32 s45, s45, 1
    s_cbranch_scc1 L_rf_6
    s_waitcnt lgkmcnt(0)
    s_cmp_lg_u32 s43, s52
    s_cbranch_scc1 L_rp_5
L_rd_8:
    s_lshr_b32 s44, s40, 5
    s_and_b32 s44, s44, 0x3ff800
    s_lshl_b32 s45, s40, 11
    s_and_b32 s45, s45, 0x3ff800
    v_mov_b32 v8, s44
    v_mov_b32 v9, s45
    s_and_b32 s44, s41, 0xffff0000
    s_lshl_b32 s45, s41, 16
    v_mov_b32 v10, s44
    v_mov_b32 v11, s45
    v_cndmask_b32 v8, v8, v9, s[56:57]
    v_cndmask_b32 v10, v10, v11, s[56:57]
    v_add_u32 v4, v4, v8
    global_load_ushort v6, v4, s[4:5]
    v_ashrrev_i32 v11, 31, v10
    v_not_b32 v11, v11
    v_or_b32 v11, 0x80000000, v11
    v_xor_b32 v10, v10, v11
    v_and_b32 v10, 0xffff0000, v10
    v_mul_f32 v10, 0xbfb8aa3b, v10
    v_exp_f32 v10, v10
    s_mov_b32 s58, 65536
    v_add_f32 v10, 1.0, v10
    v_rcp_f32 v10, v10
    s_mov_b32 s59, 200
    v_cvt_pk_bf16_f32 v10, v10, v10
    v_and_b32 v7, 0xffff0000, v10
    s_mov_b32 exec_lo, 0x0fffffff
    s_mov_b32 exec_hi, 0
L_hint:
    buffer_load_dword v8, v41, s[28:31], s48 offen sc1
    s_sub_u32 s59, s59, 1
    s_cbranch_scc1 L_hint_done
    s_waitcnt vmcnt(0)
    v_cmp_ne_u32 vcc, s52, v8
    s_cbranch_vccnz L_hint
L_hint_done:
    s_mov_b64 exec, -1
    s_waitcnt vmcnt(0)
    v_lshlrev_b32 v6, 16, v6
    s_sleep 12
L_poll3:
    buffer_load_dwordx4 v[8:11], v3, s[36:39], s60 offen sc1
    buffer_load_dwordx4 v[12:15], v3, s[36:39], s61 offen sc1
    buffer_load_dwordx4 v[16:19], v3, s[36:39], s62 offen sc1
    buffer_load_dwordx4 v[20:23], v3, s[36:39], s63 offen sc1
    buffer_load_dwordx4 v[24:27], v3, s[36:39], s64 offen sc1
    buffer_load_dwordx4 v[28:31], v3, s[36:39], s65 offen sc1
    buffer_load_dwordx4 v[32:35], v3, s[36:39], s66 offen sc1
    s_sub_u32 s58, s58, 1
    s_cbranch_scc1 L_poll3_done
    s_waitcnt vmcnt(5)
    v_xor_b32 v8, v8, v40
    v_xor_b32 v12, v12, v40
    v_or_b32 v36, v8, v12
    v_pk_add_f32 v[8:9], v[8:9], v[12:13]
    v_pk_add_f32 v[10:11], v[10:11], v[14:15]
    s_waitcnt vmcnt(4)
    v_xor_b32 v16, v16, v40
    v_pk_add_f32 v[10:11], v[10:11], v[18:19]
    v_pk_add_f32 v[8:9], v[8:9], v[16:17]
    v_or_b32 v36, v36, v16
    s_waitcnt vmcnt(3)
    v_xor_b32 v20, v20, v40
    v_pk_add_f32 v[10:11], v[10:11], v[22:23]
    v_pk_add_f32 v[8:9], v[8:9], v[20:21]
    v_or_b32 v36, v36, v20
    s_waitcnt vmcnt(2)
    v_xor_b32 v24, v24, v40
    v_pk_add_f32 v[10:11], v[10:11], v[26:27]
    v_pk_add_f32 v[8:9], v[8:9], v[24:25]
    v_or_b32 v36, v36, v24
    s_waitcnt vmcnt(1)
    v_xor_b32 v28, v28, v40
    v_pk_add_f32 v[10:11], v[10:11], v[30:31]
    v_pk_add_f32 v[8:9], v[8:9], v[28:29]
    v_or_b32 v36, v36, v28
    s_waitcnt vmcnt(0)
    v_xor_b32 v32, v32, v40
    v_pk_add_f32 v[10:11], v[10:11], v[34:35]
    v_pk_add_f32 v[8:9], v[8:9], v[32:33]
    v_bitop3_b32 v36, v36, v32, 15 bitop3:0xa8
    v_cmp_ne_u32 vcc, 0, v36
    v_permlane32_swap_b32 v8, v9
    s_cbranch_vccnz L_poll3
L_poll3_done:
    v_permlane32_swap_b32 v10, v11
    v_add_f32 v8, v8, v9
    v_add_f32 v10, v10, v11
    s_nop 1
    v_permlane16_swap_b32 v8, v10
    v_add_f32 v8, v8, v10
    s_nop 1
    v_add_f32_dpp v5, v8, v8 row_ror:8 row_mask:0xf bank_mask:0xf
    s_mov_b32 exec_lo, 0x00ff00ff
    s_mov_b32 exec_hi, 0x00ff00ff
    v_cvt_pk_bf16_f32 v5, v5, v5
    v_and_b32 v5, 0xffff0000, v5
    v_mul_f32 v5, v5, v7
    v_cvt_pk_bf16_f32 v5, v5, v5
    v_and_b32 v5, 0xffff0000, v5
    v_add_f32 v5, v5, v6
    v_cvt_pk_bf16_f32 v5, v5, v5
    global_store_short v4, v5, s[14:15]
    s_endpgm
L_AGG:
    s_setprio 3
    s_and_b32 s32, s2, 7
    v_lshlrev_b32 v1, 7, v0
    s_lshl_b32 s33, s32, 13
    s_add_u32 s33, s33, 4096
    s_lshl_b32 s34, s32, 8
    s_add_u32 s34, s34, 73728
    s_bfe_u32 s53, s2, 0x20003
    s_mul_i32 s36, s32, 2304
    s_add_u32 s36, s36, 131072
    s_mov_b32 s28, s18
    s_mov_b32 s29, s19
    s_mov_b32 s30, 268435456
    s_mov_b32 s31, 0x20000
    v_lshlrev_b32 v93, 5, v0
    v_sub_u32 v88, 2040, v93
    v_subrev_u32 v89, 8, v88
    v_subrev_u32 v90, 16, v88
    v_subrev_u32 v91, 24, v88
    v_lshlrev_b32 v2, 4, v0
    v_add_u32 v4, 7, v0
    v_and_b32 v4, 7, v4
    v_cmp_ne_u32 vcc, 7, v4
    v_cmp_gt_u32 s[58:59], 32, v0
    v_lshl_add_u32 v4, v4, 5, v0
    v_lshlrev_b32 v4, 3, v4
    v_sub_u32 v4, 2040, v4
    s_and_b64 s[58:59], s[58:59], vcc
    v_cndmask_b32 v72, 0, -1, s[58:59]
    v_and_b32 v73, v4, v72
    v_and_b32 v74, 31, v0
    v_lshlrev_b32 v74, 3, v74
    s_mul_i32 s50, s46, 0x9e3779b8
    s_add_u32 s50, s50, 0x3c6ef372
    s_xor_b32 s51, s50, 0xa5a5a5a8
    s_mul_i32 s52, s46, 0x85ebca6b
    s_add_u32 s52, s52, 0x27d4eb2f
    v_mov_b32 v83, s52
    s_mov_b32 s52, 65536
    v_mov_b32 v82, 0
    v_mov_b32 v70, 0
    v_mov_b32 v71, 0
    v_mov_b32 v92, 0x07060302
    v_mov_b32 v94, 0x05040100
    s_mov_b32 s55, 0x07ff07ff
    s_mov_b64 s[56:57], -1
    s_barrier
L_poll1:
    buffer_load_dwordx4 v[60:63], v93, s[28:31], s36 offen sc1
    buffer_load_dwordx4 v[64:67], v93, s[28:31], s36 offen offset:16 sc1
    buffer_load_dwordx2 v[68:69], v74, s[28:31], s36 offen offset:2048 sc1
    s_sub_u32 s52, s52, 1
    s_cbranch_scc1 L_poll1_done
    s_cmp_lg_u64 s[56:57], -1
    s_cbranch_scc1 L_spec
    s_waitcnt vmcnt(0)
L_specdone:
    v_xor_b32 v60, s50, v60
    v_xor_b32 v61, s51, v61
    v_xor_b32 v62, s50, v62
    v_xor_b32 v63, s51, v63
    v_xor_b32 v64, s50, v64
    v_xor_b32 v65, s51, v65
    v_xor_b32 v66, s50, v66
    v_xor_b32 v67, s51, v67
    v_bitop3_b32 v68, v68, s50, v72 bitop3:0x28
    v_bitop3_b32 v69, v69, s51, v72 bitop3:0x28
    v_bitop3_b32 v84, v60, v61, v88 bitop3:0x7e
    v_bitop3_b32 v85, v62, v63, v89 bitop3:0x7e
    v_bitop3_b32 v86, v64, v65, v90 bitop3:0x7e
    v_bitop3_b32 v87, v66, v67, v91 bitop3:0x7e
    v_bitop3_b32 v75, v68, v69, v73 bitop3:0x7e
    v_or3_b32 v84, v84, v85, v86
    v_or3_b32 v84, v84, v87, v75
    v_and_b32 v84, 0xf80007f8, v84
    v_cmp_ne_u32 vcc, 0, v84
    v_min_u32 v84, v60, v62
    v_max_u32 v60, v60, v62
    v_max3_u32 v61, v61, v63, v84
    v_min_u32 v85, v64, v66
    v_max_u32 v64, v64, v66
    v_max3_u32 v65, v65, v67, v85
    v_min_u32 v85, v64, v68
    v_max_u32 v64, v64, v68
    v_max3_u32 v65, v65, v69, v85
    s_andn2_b64 exec, exec, vcc
    v_min_u32 v84, v60, v64
    v_max_u32 v70, v60, v64
    v_max3_u32 v71, v61, v65, v84
    s_and_b64 s[56:57], s[56:57], vcc
    s_mov_b64 exec, s[56:57]
    s_cbranch_scc1 L_poll1
L_poll1_done:
    s_mov_b64 exec, -1
    s_nop 1
    v_min_u32_dpp v84, v70, v70 quad_perm:[1,0,3,2] row_mask:0xf bank_mask:0xf
    v_max_u32_dpp v85, v71, v71 quad_perm:[1,0,3,2] row_mask:0xf bank_mask:0xf
    v_max_u32_dpp v76, v70, v70 quad_perm:[1,0,3,2] row_mask:0xf bank_mask:0xf
    v_max_u32 v77, v84, v85
    s_nop 0
    v_min_u32_dpp v84, v76, v76 quad_perm:[2,3,0,1] row_mask:0xf bank_mask:0xf
    v_max_u32_dpp v85, v77, v77 quad_perm:[2,3,0,1] row_mask:0xf bank_mask:0xf
    v_max_u32_dpp v76, v76, v76 quad_perm:[2,3,0,1] row_mask:0xf bank_mask:0xf
    v_max_u32 v77, v84, v85
    s_nop 0
    v_min_u32_dpp v84, v76, v76 row_half_mirror row_mask:0xf bank_mask:0xf
    v_max_u32_dpp v85, v77, v77 row_half_mirror row_mask:0xf bank_mask:0xf
    v_max_u32_dpp v76, v76, v76 row_half_mirror row_mask:0xf bank_mask:0xf
    v_max_u32 v77, v84, v85
    s_nop 0
    v_min_u32_dpp v84, v76, v76 row_mirror row_mask:0xf bank_mask:0xf
    v_max_u32_dpp v85, v77, v77 row_mirror row_mask:0xf bank_mask:0xf
    v_max_u32_dpp v78, v76, v76 row_mirror row_mask:0xf bank_mask:0xf
    v_max_u32_dpp v76, v76, v76 row_mirror row_mask:0xf bank_mask:0xf
    v_max_u32 v79, v84, v85
    v_max_u32 v77, v84, v85
    v_permlane16_swap_b32 v76, v78
    s_nop 0
    v_permlane16_swap_b32 v77, v79
    v_min_u32 v84, v76, v78
    v_max_u32 v86, v76, v78
    v_max_u32 v76, v76, v78
    v_max3_u32 v87, v77, v79, v84
    v_max3_u32 v77, v77, v79, v84
    v_permlane32_swap_b32 v76, v86
    s_nop 0
    v_permlane32_swap_b32 v77, v87
    v_min_u32 v84, v76, v86
    v_max_u32 v76, v76, v86
    v_max3_u32 v77, v77, v87, v84
    v_perm_b32 v80, v76, v77, v94
    v_bitop3_b32 v80, v80, s55, v80 bitop3:0x0c
    v_lshlrev_b32 v84, 5, v76
    v_lshlrev_b32 v85, 5, v77
    v_perm_b32 v81, v84, v85, v92
    buffer_store_dwordx4 v[80:83], v1, s[28:31], s33 offen
    v_bfe_u32 v4, v80, 16, 11
    v_and_b32 v5, 0x7ff, v80
    v_lshl_or_b32 v4, v4, 11, v2
    v_lshl_or_b32 v5, v5, 11, v2
    global_load_dwordx4 v[8:11], v4, s[4:5]
    global_load_dwordx4 v[12:15], v5, s[4:5]
    global_load_dwordx4 v[16:19], v4, s[4:5] offset:1024
    global_load_dwordx4 v[20:23], v5, s[4:5] offset:1024
    v_mov_b32 v3, 0
    s_mov_b64 exec, 1
    buffer_store_dwordx4 v[80:83], v3, s[28:31], s34 offen sc1
    s_cmp_lg_u32 s2, 224
    s_cbranch_scc1 L_agg_done
    s_add_u32 s46, s46, 1
    v_mov_b32 v85, s46
    buffer_store_dword v85, v3, s[28:31], 0 offen sc1
L_agg_done:
    s_endpgm
L_rf_2:
    s_and_b32 s44, s2, 7
    s_lshl_b32 s44, s44, 8
    s_add_u32 s44, s44, 73728
    s_mov_b32 s45, 65536
L_rg_3:
    s_waitcnt lgkmcnt(0)
    s_load_dwordx4 s[40:43], s[18:19], s44 glc
    s_waitcnt lgkmcnt(0)
    s_cmp_eq_u32 s43, s52
    s_cbranch_scc1 L_rd_4
    s_sleep 8
    s_sub_u32 s45, s45, 1
    s_cbranch_scc0 L_rg_3
    s_and_b32 s40, s40, 0x7ff07ff
    s_branch L_rd_4
L_p2sw:
    s_waitcnt vmcnt(0)
    s_cmp_ge_u32 s41, 655360
    s_cbranch_scc1 L_poll2_done
    s_mov_b32 s42, 65536
    s_add_u32 s40, s27, 5
    s_add_u32 s46, s27, 10
    s_add_u32 s47, s27, 15
L_p2own:
    buffer_load_dwordx4 v[8:11], v65, s[28:31], s44 offen sc1
    s_sub_u32 s42, s42, 1
    s_cbranch_scc1 L_p2own_done
    s_waitcnt vmcnt(0)
    v_xor_b32 v12, s27, v8
    v_bitop3_b32 v12, v9, s40, v12 bitop3:0xbe
    v_bitop3_b32 v12, v10, s46, v12 bitop3:0xbe
    v_bitop3_b32 v12, v11, s47, v12 bitop3:0xbe
    v_and_b32 v12, 15, v12
    v_cmp_ne_u32 vcc, 0, v12
    s_cbranch_vccnz L_p2own
L_p2own_done:
    s_waitcnt vmcnt(0)
    s_add_u32 s45, s44, 262144
    buffer_store_dwordx4 v[8:11], v65, s[28:31], s45 offen sc1
    s_add_u32 s41, s41, 262144
    s_mov_b32 s42, 65536
    s_branch L_poll2
L_rf_6:
    s_and_b32 s44, s2, 7
    s_lshl_b32 s44, s44, 8
    s_add_u32 s44, s44, 73728
    s_mov_b32 s45, 65536
L_rg_7:
    s_waitcnt lgkmcnt(0)
    s_load_dwordx4 s[40:43], s[18:19], s44 glc
    s_waitcnt lgkmcnt(0)
    s_cmp_eq_u32 s43, s52
    s_cbranch_scc1 L_rd_8
    s_sleep 8
    s_sub_u32 s45, s45, 1
    s_cbranch_scc0 L_rg_7
    s_and_b32 s40, s40, 0x7ff07ff
    s_branch L_rd_8
L_spec:
    s_mov_b64 exec, -1
    s_nop 1
    v_min_u32_dpp v84, v70, v70 quad_perm:[1,0,3,2] row_mask:0xf bank_mask:0xf
    v_max_u32_dpp v85, v71, v71 quad_perm:[1,0,3,2] row_mask:0xf bank_mask:0xf
    v_max_u32_dpp v76, v70, v70 quad_perm:[1,0,3,2] row_mask:0xf bank_mask:0xf
    v_max_u32 v77, v84, v85
    s_nop 0
    v_min_u32_dpp v84, v76, v76 quad_perm:[2,3,0,1] row_mask:0xf bank_mask:0xf
    v_max_u32_dpp v85, v77, v77 quad_perm:[2,3,0,1] row_mask:0xf bank_mask:0xf
    v_max_u32_dpp v76, v76, v76 quad_perm:[2,3,0,1] row_mask:0xf bank_mask:0xf
    v_max_u32 v77, v84, v85
    s_nop 0
    v_min_u32_dpp v84, v76, v76 row_half_mirror row_mask:0xf bank_mask:0xf
    v_max_u32_dpp v85, v77, v77 row_half_mirror row_mask:0xf bank_mask:0xf
    v_max_u32_dpp v76, v76, v76 row_half_mirror row_mask:0xf bank_mask:0xf
    v_max_u32 v77, v84, v85
    s_nop 0
    v_min_u32_dpp v84, v76, v76 row_mirror row_mask:0xf bank_mask:0xf
    v_max_u32_dpp v85, v77, v77 row_mirror row_mask:0xf bank_mask:0xf
    v_max_u32_dpp v78, v76, v76 row_mirror row_mask:0xf bank_mask:0xf
    v_max_u32_dpp v76, v76, v76 row_mirror row_mask:0xf bank_mask:0xf
    v_max_u32 v79, v84, v85
    v_max_u32 v77, v84, v85
    v_permlane16_swap_b32 v76, v78
    s_nop 0
    v_permlane16_swap_b32 v77, v79
    v_min_u32 v84, v76, v78
    v_max_u32 v86, v76, v78
    v_max_u32 v76, v76, v78
    v_max3_u32 v87, v77, v79, v84
    v_max3_u32 v77, v77, v79, v84
    v_permlane32_swap_b32 v76, v86
    s_nop 0
    v_permlane32_swap_b32 v77, v87
    v_min_u32 v84, v76, v86
    v_max_u32 v76, v76, v86
    v_max3_u32 v77, v77, v87, v84
    v_perm_b32 v80, v76, v77, v94
    v_bitop3_b32 v80, v80, s55, v80 bitop3:0x0c
    v_bfe_u32 v4, v80, 16, 11
    v_and_b32 v5, 0x7ff, v80
    v_lshl_or_b32 v4, v4, 11, v2
    v_lshl_or_b32 v5, v5, 11, v2
    global_load_dwordx4 v[8:11], v4, s[4:5]
    global_load_dwordx4 v[12:15], v5, s[4:5]
    global_load_dwordx4 v[16:19], v4, s[4:5] offset:1024
    global_load_dwordx4 v[20:23], v5, s[4:5] offset:1024
    s_mov_b64 exec, s[56:57]
    s_waitcnt vmcnt(4)
    s_branch L_specdone
L_hot_end:
L_nanfix:
    s_mov_b32 s54, 0x07060302
    v_and_b32 v84, 0xffff0000, v10
    v_lshlrev_b32 v85, 16, v10
    v_and_b32 v86, 0xffff0000, v11
    v_lshlrev_b32 v87, 16, v11
    v_fma_f32 v84, v84, 0, v84
    v_fma_f32 v85, v85, 0, v85
    v_fma_f32 v86, v86, 0, v86
    v_fma_f32 v87, v87, 0, v87
    v_perm_b32 v10, v84, v85, s54
    v_perm_b32 v11, v86, v87, s54
    v_and_b32 v84, 0xffff0000, v12
    v_lshlrev_b32 v85, 16, v12
    v_and_b32 v86, 0xffff0000, v13
    v_lshlrev_b32 v87, 16, v13
    v_fma_f32 v84, v84, 0, v84
    v_fma_f32 v85, v85, 0, v85
    v_fma_f32 v86, v86, 0, v86
    v_fma_f32 v87, v87, 0, v87
    v_perm_b32 v12, v84, v85, s54
    v_perm_b32 v13, v86, v87, s54
    v_and_b32 v84, 0xffff0000, v14
    v_lshlrev_b32 v85, 16, v14
    v_and_b32 v86, 0xffff0000, v15
    v_lshlrev_b32 v87, 16, v15
    v_fma_f32 v84, v84, 0, v84
    v_fma_f32 v85, v85, 0, v85
    v_fma_f32 v86, v86, 0, v86
    v_fma_f32 v87, v87, 0, v87
    v_perm_b32 v14, v84, v85, s54
    v_perm_b32 v15, v86, v87, s54
    v_and_b32 v84, 0xffff0000, v16
    v_lshlrev_b32 v85, 16, v16
    v_and_b32 v86, 0xffff0000, v17
    v_lshlrev_b32 v87, 16, v17
    v_fma_f32 v84, v84, 0, v84
    v_fma_f32 v85, v85, 0, v85
    v_fma_f32 v86, v86, 0, v86
    v_fma_f32 v87, v87, 0, v87
    v_perm_b32 v16, v84, v85, s54
    v_perm_b32 v17, v86, v87, s54
    v_and_b32 v84, 0xffff0000, v18
    v_lshlrev_b32 v85, 16, v18
    v_and_b32 v86, 0xffff0000, v19
    v_lshlrev_b32 v87, 16, v19
    v_fma_f32 v84, v84, 0, v84
    v_fma_f32 v85, v85, 0, v85
    v_fma_f32 v86, v86, 0, v86
    v_fma_f32 v87, v87, 0, v87
    v_perm_b32 v18, v84, v85, s54
    v_perm_b32 v19, v86, v87, s54
    v_and_b32 v84, 0xffff0000, v20
    v_lshlrev_b32 v85, 16, v20
    v_and_b32 v86, 0xffff0000, v21
    v_lshlrev_b32 v87, 16, v21
    v_fma_f32 v84, v84, 0, v84
    v_fma_f32 v85, v85, 0, v85
    v_fma_f32 v86, v86, 0, v86
    v_fma_f32 v87, v87, 0, v87
    v_perm_b32 v20, v84, v85, s54
    v_perm_b32 v21, v86, v87, s54
    v_and_b32 v84, 0xffff0000, v22
    v_lshlrev_b32 v85, 16, v22
    v_and_b32 v86, 0xffff0000, v23
    v_lshlrev_b32 v87, 16, v23
    v_fma_f32 v84, v84, 0, v84
    v_fma_f32 v85, v85, 0, v85
    v_fma_f32 v86, v86, 0, v86
    v_fma_f32 v87, v87, 0, v87
    v_perm_b32 v22, v84, v85, s54
    v_perm_b32 v23, v86, v87, s54
    v_and_b32 v84, 0xffff0000, v24
    v_lshlrev_b32 v85, 16, v24
    v_and_b32 v86, 0xffff0000, v25
    v_lshlrev_b32 v87, 16, v25
    v_fma_f32 v84, v84, 0, v84
    v_fma_f32 v85, v85, 0, v85
    v_fma_f32 v86, v86, 0, v86
    v_fma_f32 v87, v87, 0, v87
    v_perm_b32 v24, v84, v85, s54
    v_perm_b32 v25, v86, v87, s54
    v_and_b32 v84, 0xffff0000, v26
    v_lshlrev_b32 v85, 16, v26
    v_and_b32 v86, 0xffff0000, v27
    v_lshlrev_b32 v87, 16, v27
    v_fma_f32 v84, v84, 0, v84
    v_fma_f32 v85, v85, 0, v85
    v_fma_f32 v86, v86, 0, v86
    v_fma_f32 v87, v87, 0, v87
    v_perm_b32 v26, v84, v85, s54
    v_perm_b32 v27, v86, v87, s54
    v_and_b32 v84, 0xffff0000, v28
    v_lshlrev_b32 v85, 16, v28
    v_and_b32 v86, 0xffff0000, v29
    v_lshlrev_b32 v87, 16, v29
    v_fma_f32 v84, v84, 0, v84
    v_fma_f32 v85, v85, 0, v85
    v_fma_f32 v86, v86, 0, v86
    v_fma_f32 v87, v87, 0, v87
    v_perm_b32 v28, v84, v85, s54
    v_perm_b32 v29, v86, v87, s54
    v_and_b32 v84, 0xffff0000, v30
    v_lshlrev_b32 v85, 16, v30
    v_and_b32 v86, 0xffff0000, v31
    v_lshlrev_b32 v87, 16, v31
    v_fma_f32 v84, v84, 0, v84
    v_fma_f32 v85, v85, 0, v85
    v_fma_f32 v86, v86, 0, v86
    v_fma_f32 v87, v87, 0, v87
    v_perm_b32 v30, v84, v85, s54
    v_perm_b32 v31, v86, v87, s54
    v_and_b32 v84, 0xffff0000, v32
    v_lshlrev_b32 v85, 16, v32
    v_and_b32 v86, 0xffff0000, v33
    v_lshlrev_b32 v87, 16, v33
    v_fma_f32 v84, v84, 0, v84
    v_fma_f32 v85, v85, 0, v85
    v_fma_f32 v86, v86, 0, v86
    v_fma_f32 v87, v87, 0, v87
    v_perm_b32 v32, v84, v85, s54
    v_perm_b32 v33, v86, v87, s54
    v_and_b32 v84, 0xffff0000, v34
    v_lshlrev_b32 v85, 16, v34
    v_and_b32 v86, 0xffff0000, v35
    v_lshlrev_b32 v87, 16, v35
    v_fma_f32 v84, v84, 0, v84
    v_fma_f32 v85, v85, 0, v85
    v_fma_f32 v86, v86, 0, v86
    v_fma_f32 v87, v87, 0, v87
    v_perm_b32 v34, v84, v85, s54
    v_perm_b32 v35, v86, v87, s54
    v_and_b32 v84, 0xffff0000, v36
    v_lshlrev_b32 v85, 16, v36
    v_and_b32 v86, 0xffff0000, v37
    v_lshlrev_b32 v87, 16, v37
    v_fma_f32 v84, v84, 0, v84
    v_fma_f32 v85, v85, 0, v85
    v_fma_f32 v86, v86, 0, v86
    v_fma_f32 v87, v87, 0, v87
    v_perm_b32 v36, v84, v85, s54
    v_perm_b32 v37, v86, v87, s54
    v_and_b32 v84, 0xffff0000, v38
    v_lshlrev_b32 v85, 16, v38
    v_and_b32 v86, 0xffff0000, v39
    v_lshlrev_b32 v87, 16, v39
    v_fma_f32 v84, v84, 0, v84
    v_fma_f32 v85, v85, 0, v85
    v_fma_f32 v86, v86, 0, v86
    v_fma_f32 v87, v87, 0, v87
    v_perm_b32 v38, v84, v85, s54
    v_perm_b32 v39, v86, v87, s54
    v_and_b32 v84, 0xffff0000, v40
    v_lshlrev_b32 v85, 16, v40
    v_and_b32 v86, 0xffff0000, v41
    v_lshlrev_b32 v87, 16, v41
    v_fma_f32 v84, v84, 0, v84
    v_fma_f32 v85, v85, 0, v85
    v_fma_f32 v86, v86, 0, v86
    v_fma_f32 v87, v87, 0, v87
    v_perm_b32 v40, v84, v85, s54
    v_perm_b32 v41, v86, v87, s54
    v_and_b32 v84, 0xffff0000, v42
    v_lshlrev_b32 v85, 16, v42
    v_and_b32 v86, 0xffff0000, v43
    v_lshlrev_b32 v87, 16, v43
    v_fma_f32 v84, v84, 0, v84
    v_fma_f32 v85, v85, 0, v85
    v_fma_f32 v86, v86, 0, v86
    v_fma_f32 v87, v87, 0, v87
    v_perm_b32 v42, v84, v85, s54
    v_perm_b32 v43, v86, v87, s54
    v_and_b32 v84, 0xffff0000, v44
    v_lshlrev_b32 v85, 16, v44
    v_and_b32 v86, 0xffff0000, v45
    v_lshlrev_b32 v87, 16, v45
    v_fma_f32 v84, v84, 0, v84
    v_fma_f32 v85, v85, 0, v85
    v_fma_f32 v86, v86, 0, v86
    v_fma_f32 v87, v87, 0, v87
    v_perm_b32 v44, v84, v85, s54
    v_perm_b32 v45, v86, v87, s54
    v_and_b32 v84, 0xffff0000, v46
    v_lshlrev_b32 v85, 16, v46
    v_and_b32 v86, 0xffff0000, v47
    v_lshlrev_b32 v87, 16, v47
    v_fma_f32 v84, v84, 0, v84
    v_fma_f32 v85, v85, 0, v85
    v_fma_f32 v86, v86, 0, v86
    v_fma_f32 v87, v87, 0, v87
    v_perm_b32 v46, v84, v85, s54
    v_perm_b32 v47, v86, v87, s54
    v_and_b32 v84, 0xffff0000, v48
    v_lshlrev_b32 v85, 16, v48
    v_and_b32 v86, 0xffff0000, v49
    v_lshlrev_b32 v87, 16, v49
    v_fma_f32 v84, v84, 0, v84
    v_fma_f32 v85, v85, 0, v85
    v_fma_f32 v86, v86, 0, v86
    v_fma_f32 v87, v87, 0, v87
    v_perm_b32 v48, v84, v85, s54
    v_perm_b32 v49, v86, v87, s54
    v_and_b32 v84, 0xffff0000, v50
    v_lshlrev_b32 v85, 16, v50
    v_and_b32 v86, 0xffff0000, v51
    v_lshlrev_b32 v87, 16, v51
    v_fma_f32 v84, v84, 0, v84
    v_fma_f32 v85, v85, 0, v85
    v_fma_f32 v86, v86, 0, v86
    v_fma_f32 v87, v87, 0, v87
    v_perm_b32 v50, v84, v85, s54
    v_perm_b32 v51, v86, v87, s54
    v_and_b32 v84, 0xffff0000, v52
    v_lshlrev_b32 v85, 16, v52
    v_and_b32 v86, 0xffff0000, v53
    v_lshlrev_b32 v87, 16, v53
    v_fma_f32 v84, v84, 0, v84
    v_fma_f32 v85, v85, 0, v85
    v_fma_f32 v86, v86, 0, v86
    v_fma_f32 v87, v87, 0, v87
    v_perm_b32 v52, v84, v85, s54
    v_perm_b32 v53, v86, v87, s54
    v_and_b32 v84, 0xffff0000, v54
    v_lshlrev_b32 v85, 16, v54
    v_and_b32 v86, 0xffff0000, v55
    v_lshlrev_b32 v87, 16, v55
    v_fma_f32 v84, v84, 0, v84
    v_fma_f32 v85, v85, 0, v85
    v_fma_f32 v86, v86, 0, v86
    v_fma_f32 v87, v87, 0, v87
    v_perm_b32 v54, v84, v85, s54
    v_perm_b32 v55, v86, v87, s54
    v_and_b32 v84, 0xffff0000, v56
    v_lshlrev_b32 v85, 16, v56
    v_and_b32 v86, 0xffff0000, v57
    v_lshlrev_b32 v87, 16, v57
    v_fma_f32 v84, v84, 0, v84
    v_fma_f32 v85, v85, 0, v85
    v_fma_f32 v86, v86, 0, v86
    v_fma_f32 v87, v87, 0, v87
    v_perm_b32 v56, v84, v85, s54
    v_perm_b32 v57, v86, v87, s54
    v_and_b32 v84, 0xffff0000, v58
    v_lshlrev_b32 v85, 16, v58
    v_and_b32 v86, 0xffff0000, v59
    v_lshlrev_b32 v87, 16, v59
    v_fma_f32 v84, v84, 0, v84
    v_fma_f32 v85, v85, 0, v85
    v_fma_f32 v86, v86, 0, v86
    v_fma_f32 v87, v87, 0, v87
    v_perm_b32 v58, v84, v85, s54
    v_perm_b32 v59, v86, v87, s54
    v_and_b32 v84, 0xffff0000, v60
    v_lshlrev_b32 v85, 16, v60
    v_and_b32 v86, 0xffff0000, v61
    v_lshlrev_b32 v87, 16, v61
    v_fma_f32 v84, v84, 0, v84
    v_fma_f32 v85, v85, 0, v85
    v_fma_f32 v86, v86, 0, v86
    v_fma_f32 v87, v87, 0, v87
    v_perm_b32 v60, v84, v85, s54
    v_perm_b32 v61, v86, v87, s54
    v_and_b32 v84, 0xffff0000, v62
    v_lshlrev_b32 v85, 16, v62
    v_and_b32 v86, 0xffff0000, v63
    v_lshlrev_b32 v87, 16, v63
    v_fma_f32 v84, v84, 0, v84
    v_fma_f32 v85, v85, 0, v85
    v_fma_f32 v86, v86, 0, v86
    v_fma_f32 v87, v87, 0, v87
    v_perm_b32 v62, v84, v85, s54
    v_perm_b32 v63, v86, v87, s54
    v_and_b32 v84, 0xffff0000, v64
    v_lshlrev_b32 v85, 16, v64
    v_and_b32 v86, 0xffff0000, v65
    v_lshlrev_b32 v87, 16, v65
    v_fma_f32 v84, v84, 0, v84
    v_fma_f32 v85, v85, 0, v85
    v_fma_f32 v86, v86, 0, v86
    v_fma_f32 v87, v87, 0, v87
    v_perm_b32 v64, v84, v85, s54
    v_perm_b32 v65, v86, v87, s54
    v_and_b32 v84, 0xffff0000, v66
    v_lshlrev_b32 v85, 16, v66
    v_and_b32 v86, 0xffff0000, v67
    v_lshlrev_b32 v87, 16, v67
    v_fma_f32 v84, v84, 0, v84
    v_fma_f32 v85, v85, 0, v85
    v_fma_f32 v86, v86, 0, v86
    v_fma_f32 v87, v87, 0, v87
    v_perm_b32 v66, v84, v85, s54
    v_perm_b32 v67, v86, v87, s54
    v_and_b32 v84, 0xffff0000, v68
    v_lshlrev_b32 v85, 16, v68
    v_and_b32 v86, 0xffff0000, v69
    v_lshlrev_b32 v87, 16, v69
    v_fma_f32 v84, v84, 0, v84
    v_fma_f32 v85, v85, 0, v85
    v_fma_f32 v86, v86, 0, v86
    v_fma_f32 v87, v87, 0, v87
    v_perm_b32 v68, v84, v85, s54
    v_perm_b32 v69, v86, v87, s54
    v_and_b32 v84, 0xffff0000, v70
    v_lshlrev_b32 v85, 16, v70
    v_and_b32 v86, 0xffff0000, v71
    v_lshlrev_b32 v87, 16, v71
    v_fma_f32 v84, v84, 0, v84
    v_fma_f32 v85, v85, 0, v85
    v_fma_f32 v86, v86, 0, v86
    v_fma_f32 v87, v87, 0, v87
    v_perm_b32 v70, v84, v85, s54
    v_perm_b32 v71, v86, v87, s54
    v_and_b32 v84, 0xffff0000, v72
    v_lshlrev_b32 v85, 16, v72
    v_and_b32 v86, 0xffff0000, v73
    v_lshlrev_b32 v87, 16, v73
    v_fma_f32 v84, v84, 0, v84
    v_fma_f32 v85, v85, 0, v85
    v_fma_f32 v86, v86, 0, v86
    v_fma_f32 v87, v87, 0, v87
    v_perm_b32 v72, v84, v85, s54
    v_perm_b32 v73, v86, v87, s54
    s_branch L_nanfix_done
L_end:
    s_endpgm

.section .rodata,"a"
.p2align 6
.amdhsa_kernel standalone__moe_arch_mod__prompt_kernel
  .amdhsa_next_free_vgpr 96
  .amdhsa_next_free_sgpr 102
  .amdhsa_accum_offset 96
  .amdhsa_group_segment_fixed_size 0
  .amdhsa_kernarg_size 64
  .amdhsa_user_sgpr_count 2
  .amdhsa_user_sgpr_kernarg_segment_ptr 1
  .amdhsa_system_sgpr_workgroup_id_x 1
  .amdhsa_float_denorm_mode_32 3
.end_amdhsa_kernel
```
